```python
import torch

def _softmax(x, axis=-1):
    return torch.softmax(x, dim=axis)
def _gelu(x):
    return torch.nn.functional.gelu(x, approximate="tanh")
def _silu(x):
    return torch.nn.functional.silu(x)
def _sigmoid(x):
    return torch.sigmoid(x)
def _layernorm(x, axis=-1, eps=1e-5):
    m = x.mean(dim=axis, keepdim=True)
    v = x.var(dim=axis, keepdim=True, unbiased=False)
    return (x - m) / torch.sqrt(v + eps)
def _scatter_add(tgt, idx, src, axis=0):
    return tgt.clone().index_add_(axis, idx, src)
def _segment_sum(src, seg, n):
    out = torch.zeros((n,) + src.shape[1:], dtype=src.dtype)
    return out.index_add_(0, seg, src)
def _pad(x, pw):
    flat = tuple(v for pair in reversed(pw) for v in pair)
    return torch.nn.functional.pad(x, flat)

kernel_name = 'standalone__paged_block_table_kv_radixattention__sampling'

def setup_inputs():

    _w = (lambda a: (lambda t: t.to(torch.bfloat16) if t.is_floating_point() else t)(torch.as_tensor(a)))
    B, H, Hkv, Dh = 8, 16, 8, 256
    Lk = 8192
    bs = 16
    nb = max(2, Lk // bs)
    P = max(1, nb // 2)
    n_phys = P + B * (nb - P)
    shared = torch.arange(P, dtype=torch.int64)
    priv = P + torch.arange(B * (nb - P), dtype=torch.int64).reshape(B, nb - P)
    bt = torch.cat([torch.tile(shared[None, :], (B, 1)), priv], dim=1)
    ctx = nb * bs - (torch.arange(1, B + 1, dtype=torch.int64) * 2654435761) % max(1, (nb * bs - P * bs) // 2)
    return {
        "q": _w((lambda *s: torch.randn(*s, dtype=torch.bfloat16) * 0.8)(B, H, Dh)),
        "k_cache": _w((lambda *s: torch.randn(*s, dtype=torch.bfloat16) * 0.8)(n_phys, bs, Hkv, Dh)),
        "v_cache": _w((lambda *s: torch.randn(*s, dtype=torch.bfloat16) * 0.05)(n_phys, bs, Hkv, Dh)),
        "block_table": _w(bt.to(torch.int64)),
        "ctx_lens": _w(torch.as_tensor(ctx).to(torch.int64)),
    }

def reference(q, k_cache, v_cache, block_table, ctx_lens):
    B, H, Dh = q.shape
    n_phys, bs, Hkv, _ = k_cache.shape
    nb = block_table.shape[1]
    Lk = nb * bs
    rep = H // Hkv
    k = k_cache[block_table].reshape(B, Lk, Hkv, Dh)
    v = v_cache[block_table].reshape(B, Lk, Hkv, Dh)
    k = (lambda x, n, axis: torch.repeat_interleave(x, n, dim=axis))(k, rep, axis=2)
    v = (lambda x, n, axis: torch.repeat_interleave(x, n, dim=axis))(v, rep, axis=2)
    scores = torch.einsum("bhd,bkhd->bhk", q, k) * (Dh ** -0.5)
    pos = torch.arange(Lk)
    valid = pos[None, :] < ctx_lens[:, None]
    scores = torch.where(valid[:, None, :], scores, -1e9)
    p = _softmax(scores, axis=-1)
    return torch.einsum("bhk,bkhd->bhd", p, v)
```

```asm
; @launch grid=(256,1,1) block=(320,1,1) lds=160064
.amdgcn_target "amdgcn-amd-amdhsa--gfx950"
.text
.globl standalone__paged_block_table_kv_radixattention__sampling_kernel
.p2align 8
.type standalone__paged_block_table_kv_radixattention__sampling_kernel,@function
standalone__paged_block_table_kv_radixattention__sampling_kernel:
    s_cmpk_ge_u32 s2, 256
    s_cbranch_scc1 L_end
    s_load_dwordx16 s[4:19], s[0:1], 0
    s_getpc_b64 s[48:49]
L_pf1:
    v_lshlrev_b32 v202, 7, v0
    v_min_u32 v202, L_end-L_pf1, v202
    global_load_dword v200, v202, s[48:49]
    v_readfirstlane_b32 s90, v0
    v_bfe_u32 v3, v0, 5, 1
    v_and_b32 v4, 31, v0
    v_lshlrev_b32 v4, 4, v4
    v_lshlrev_b32 v5, 5, v3
    s_and_b32 s70, s2, 7
    s_lshr_b32 s71, s2, 3
    s_cmp_lg_u32 s90, 0
    s_cbranch_scc1 L_cons
    v_xor_b32 v4, v4, v5
    v_lshl_add_u32 v56, v3, 12, v4
    s_lshl_b32 s68, s71, 8
    s_add_u32 s68, s68, s70
    s_lshl_b32 s92, s68, 9
    s_mov_b32 s22, 150994944
    s_mov_b32 s23, 0x20000
    v_xor_b32 v57, 64, v56
    v_add_u32 v57, 7168, v57
    v_xor_b32 v58, 128, v56
    v_add_u32 v58, 14336, v58
    v_xor_b32 v59, 192, v56
    v_add_u32 v59, 21504, v59
    s_mov_b32 m0, 0
    s_movk_i32 s56, 4096
    s_lshl_b32 s50, s56, 3
    s_mov_b32 s51, 4096000
    s_setprio 3
    s_waitcnt lgkmcnt(0)
    s_mov_b64 s[20:21], s[6:7]
L_burst:
    buffer_load_dwordx4 v56, s[20:23], s92 offen offset:0 nt lds
    buffer_load_dwordx4 v57, s[20:23], s92 offen offset:1024 nt lds
    buffer_load_dwordx4 v58, s[20:23], s92 offen offset:2048 nt lds
    buffer_load_dwordx4 v59, s[20:23], s92 offen offset:3072 nt lds
    s_add_u32 m0, m0, s56
    s_cmpk_eq_u32 m0, 16384
    s_cselect_b32 s59, s51, s50
    s_add_u32 s92, s92, s59
    s_cmpk_lg_u32 m0, 24576
    s_cbranch_scc1 L_burst
    s_lshl_b32 s44, s68, 9
    s_mov_b32 m0, 24576
    s_add_u32 s59, s44, 4259840
    buffer_load_dwordx4 v56, s[20:23], s59 offen offset:0 nt lds
    buffer_load_dwordx4 v57, s[20:23], s59 offen offset:1024 nt lds
    buffer_load_dwordx4 v58, s[20:23], s59 offen offset:2048 nt lds
    buffer_load_dwordx4 v59, s[20:23], s59 offen offset:3072 nt lds
    s_and_b32 s7, s7, 0xffff
    s_and_b32 s9, s9, 0xffff
    v_lshl_add_u32 v3, v0, 22, s44
    v_lshlrev_b32 v4, 4, v0
    v_add_u32 v4, 147456, v4
    v_mov_b32 v5, 159760
    v_add_u32 v21, 32768, v3
    v_add_u32 v22, 65536, v3
    v_add_u32 v23, 98304, v3
    s_lshl_b32 s60, s70, 5
    s_add_u32 s60, s60, s71
    s_lshl_b32 s60, s60, 13
    v_lshl_add_u32 v28, v0, 6, s60
    v_add_u32 v29, 4096, v28
    s_lshl_b32 s60, s70, 7
    s_add_u32 s60, s60, s71
    s_lshl_b32 s60, s60, 7
    s_add_u32 s60, s60, 2097152
    v_and_b32 v30, 1, v0
    v_lshl_add_u32 v30, v30, 6, s60
    v_bfe_u32 v31, v0, 1, 2
    v_lshl_add_u32 v30, v31, 12, v30
    s_mov_b32 m0, 28672
    s_add_u32 s59, s44, 4292608
    s_waitcnt vmcnt(27)
    buffer_load_dwordx4 v56, s[20:23], s59 offen offset:0 nt lds
    s_waitcnt vmcnt(27)
    buffer_load_dwordx4 v57, s[20:23], s59 offen offset:1024 nt lds
    s_waitcnt vmcnt(27)
    buffer_load_dwordx4 v58, s[20:23], s59 offen offset:2048 nt lds
    s_waitcnt vmcnt(27)
    buffer_load_dwordx4 v59, s[20:23], s59 offen offset:3072 nt lds
    s_mov_b32 m0, 32768
    s_add_u32 s59, s44, 8388608
    s_waitcnt vmcnt(27)
    buffer_load_dwordx4 v56, s[20:23], s59 offen offset:0 nt lds
    s_waitcnt vmcnt(27)
    buffer_load_dwordx4 v57, s[20:23], s59 offen offset:1024 nt lds
    s_waitcnt vmcnt(27)
    buffer_load_dwordx4 v58, s[20:23], s59 offen offset:2048 nt lds
    s_waitcnt vmcnt(27)
    buffer_load_dwordx4 v59, s[20:23], s59 offen offset:3072 nt lds
    s_mov_b32 m0, 36864
    s_add_u32 s59, s44, 8421376
    s_waitcnt vmcnt(27)
    buffer_load_dwordx4 v56, s[20:23], s59 offen offset:0 nt lds
    s_waitcnt vmcnt(27)
    buffer_load_dwordx4 v57, s[20:23], s59 offen offset:1024 nt lds
    s_waitcnt vmcnt(27)
    buffer_load_dwordx4 v58, s[20:23], s59 offen offset:2048 nt lds
    s_waitcnt vmcnt(27)
    buffer_load_dwordx4 v59, s[20:23], s59 offen offset:3072 nt lds
    s_mov_b32 m0, 40960
    s_add_u32 s59, s44, 8454144
    s_waitcnt vmcnt(27)
    buffer_load_dwordx4 v56, s[20:23], s59 offen offset:0 nt lds
    s_waitcnt vmcnt(27)
    buffer_load_dwordx4 v57, s[20:23], s59 offen offset:1024 nt lds
    s_waitcnt vmcnt(27)
    buffer_load_dwordx4 v58, s[20:23], s59 offen offset:2048 nt lds
    s_waitcnt vmcnt(27)
    buffer_load_dwordx4 v59, s[20:23], s59 offen offset:3072 nt lds
    s_mov_b32 m0, 45056
    s_add_u32 s59, s44, 8486912
    s_waitcnt vmcnt(27)
    buffer_load_dwordx4 v56, s[20:23], s59 offen offset:0 nt lds
    s_waitcnt vmcnt(27)
    buffer_load_dwordx4 v57, s[20:23], s59 offen offset:1024 nt lds
    s_waitcnt vmcnt(27)
    buffer_load_dwordx4 v58, s[20:23], s59 offen offset:2048 nt lds
    s_waitcnt vmcnt(27)
    buffer_load_dwordx4 v59, s[20:23], s59 offen offset:3072 nt lds
    s_mov_b32 m0, 49152
    s_add_u32 s59, s44, 12582912
    s_waitcnt vmcnt(27)
    buffer_load_dwordx4 v56, s[20:23], s59 offen offset:0 nt lds
    s_waitcnt vmcnt(27)
    buffer_load_dwordx4 v57, s[20:23], s59 offen offset:1024 nt lds
    s_waitcnt vmcnt(27)
    buffer_load_dwordx4 v58, s[20:23], s59 offen offset:2048 nt lds
    s_waitcnt vmcnt(27)
    buffer_load_dwordx4 v59, s[20:23], s59 offen offset:3072 nt lds
    s_mov_b32 m0, 53248
    s_add_u32 s59, s44, 12615680
    s_waitcnt vmcnt(27)
    buffer_load_dwordx4 v56, s[20:23], s59 offen offset:0 nt lds
    s_waitcnt vmcnt(27)
    buffer_load_dwordx4 v57, s[20:23], s59 offen offset:1024 nt lds
    s_waitcnt vmcnt(27)
    buffer_load_dwordx4 v58, s[20:23], s59 offen offset:2048 nt lds
    s_waitcnt vmcnt(27)
    buffer_load_dwordx4 v59, s[20:23], s59 offen offset:3072 nt lds
    s_mov_b32 m0, 57344
    s_add_u32 s59, s44, 12648448
    s_barrier
    s_waitcnt vmcnt(27)
    buffer_load_dwordx4 v56, s[20:23], s59 offen offset:0 nt lds
    s_waitcnt vmcnt(27)
    buffer_load_dwordx4 v57, s[20:23], s59 offen offset:1024 nt lds
    s_waitcnt vmcnt(27)
    buffer_load_dwordx4 v58, s[20:23], s59 offen offset:2048 nt lds
    s_waitcnt vmcnt(27)
    buffer_load_dwordx4 v59, s[20:23], s59 offen offset:3072 nt lds
    s_mov_b32 m0, 61440
    s_add_u32 s59, s44, 12681216
    s_waitcnt vmcnt(27)
    buffer_load_dwordx4 v56, s[20:23], s59 offen offset:0 nt lds
    s_waitcnt vmcnt(27)
    buffer_load_dwordx4 v57, s[20:23], s59 offen offset:1024 nt lds
    s_waitcnt vmcnt(27)
    buffer_load_dwordx4 v58, s[20:23], s59 offen offset:2048 nt lds
    s_waitcnt vmcnt(27)
    buffer_load_dwordx4 v59, s[20:23], s59 offen offset:3072 nt lds
    s_mov_b32 m0, 65536
    s_add_u32 s59, s44, 16777216
    s_waitcnt vmcnt(27)
    buffer_load_dwordx4 v56, s[20:23], s59 offen offset:0 nt lds
    s_waitcnt vmcnt(27)
    buffer_load_dwordx4 v57, s[20:23], s59 offen offset:1024 nt lds
    s_waitcnt vmcnt(27)
    buffer_load_dwordx4 v58, s[20:23], s59 offen offset:2048 nt lds
    s_waitcnt vmcnt(27)
    buffer_load_dwordx4 v59, s[20:23], s59 offen offset:3072 nt lds
    s_mov_b32 m0, 69632
    s_add_u32 s59, s44, 16809984
    s_waitcnt vmcnt(27)
    buffer_load_dwordx4 v56, s[20:23], s59 offen offset:0 nt lds
    s_waitcnt vmcnt(27)
    buffer_load_dwordx4 v57, s[20:23], s59 offen offset:1024 nt lds
    s_waitcnt vmcnt(27)
    buffer_load_dwordx4 v58, s[20:23], s59 offen offset:2048 nt lds
    s_waitcnt vmcnt(27)
    buffer_load_dwordx4 v59, s[20:23], s59 offen offset:3072 nt lds
    s_barrier
    ds_read_b128 v[36:39], v4
    ds_read_b32 v5, v5
    s_mov_b32 s50, 0
    s_mov_b32 s62, 0
    s_mov_b32 s57, 5
    s_mov_b32 s53, 6
    s_mov_b32 s58, 0
    s_waitcnt lgkmcnt(0)
    v_readfirstlane_b32 s56, v5
    v_cmp_eq_u32 vcc, v36, v3
    v_cmp_eq_u32 s[72:73], v37, v21
    v_cmp_eq_u32 s[74:75], v38, v22
    v_cmp_eq_u32 s[76:77], v39, v23
    s_min_u32 s51, s56, 30
    s_lshl1_add_u32 s92, s56, 0
    s_and_b32 s59, vcc_lo, s72
    s_and_b32 s60, s74, s76
    s_and_b32 s59, s59, s60
    s_and_b32 s60, s59, 63
    s_cmp_eq_u32 s60, 63
    s_cbranch_scc0 L_misspec
    s_waitcnt vmcnt(56)
    s_barrier
    s_mov_b32 m0, 73728
    s_add_u32 s59, s44, 16842752
    s_waitcnt vmcnt(27)
    buffer_load_dwordx4 v56, s[20:23], s59 offen offset:0 nt lds
    s_waitcnt vmcnt(27)
    buffer_load_dwordx4 v57, s[20:23], s59 offen offset:1024 nt lds
    s_waitcnt vmcnt(27)
    buffer_load_dwordx4 v58, s[20:23], s59 offen offset:2048 nt lds
    s_waitcnt vmcnt(27)
    buffer_load_dwordx4 v59, s[20:23], s59 offen offset:3072 nt lds
    s_mov_b32 m0, 77824
    s_add_u32 s59, s44, 16875520
    s_waitcnt vmcnt(27)
    buffer_load_dwordx4 v56, s[20:23], s59 offen offset:0 nt lds
    s_waitcnt vmcnt(27)
    buffer_load_dwordx4 v57, s[20:23], s59 offen offset:1024 nt lds
    s_waitcnt vmcnt(27)
    buffer_load_dwordx4 v58, s[20:23], s59 offen offset:2048 nt lds
    s_waitcnt vmcnt(27)
    buffer_load_dwordx4 v59, s[20:23], s59 offen offset:3072 nt lds
    s_waitcnt vmcnt(48)
    s_barrier
    s_mov_b32 m0, 81920
    s_add_u32 s59, s44, 20971520
    s_waitcnt vmcnt(27)
    buffer_load_dwordx4 v56, s[20:23], s59 offen offset:0 nt lds
    s_waitcnt vmcnt(27)
    buffer_load_dwordx4 v57, s[20:23], s59 offen offset:1024 nt lds
    s_waitcnt vmcnt(27)
    buffer_load_dwordx4 v58, s[20:23], s59 offen offset:2048 nt lds
    s_waitcnt vmcnt(27)
    buffer_load_dwordx4 v59, s[20:23], s59 offen offset:3072 nt lds
    s_mov_b32 m0, 86016
    s_add_u32 s59, s44, 21004288
    s_waitcnt vmcnt(27)
    buffer_load_dwordx4 v56, s[20:23], s59 offen offset:0 nt lds
    s_waitcnt vmcnt(27)
    buffer_load_dwordx4 v57, s[20:23], s59 offen offset:1024 nt lds
    s_waitcnt vmcnt(27)
    buffer_load_dwordx4 v58, s[20:23], s59 offen offset:2048 nt lds
    s_waitcnt vmcnt(27)
    buffer_load_dwordx4 v59, s[20:23], s59 offen offset:3072 nt lds
    s_waitcnt vmcnt(40)
    s_barrier
    s_mov_b32 m0, 90112
    s_add_u32 s59, s44, 21037056
    s_waitcnt vmcnt(27)
    buffer_load_dwordx4 v56, s[20:23], s59 offen offset:0 nt lds
    s_waitcnt vmcnt(27)
    buffer_load_dwordx4 v57, s[20:23], s59 offen offset:1024 nt lds
    s_waitcnt vmcnt(27)
    buffer_load_dwordx4 v58, s[20:23], s59 offen offset:2048 nt lds
    s_waitcnt vmcnt(27)
    buffer_load_dwordx4 v59, s[20:23], s59 offen offset:3072 nt lds
    s_mov_b32 m0, 94208
    s_add_u32 s59, s44, 21069824
    s_waitcnt vmcnt(27)
    buffer_load_dwordx4 v56, s[20:23], s59 offen offset:0 nt lds
    s_waitcnt vmcnt(27)
    buffer_load_dwordx4 v57, s[20:23], s59 offen offset:1024 nt lds
    s_waitcnt vmcnt(27)
    buffer_load_dwordx4 v58, s[20:23], s59 offen offset:2048 nt lds
    s_waitcnt vmcnt(27)
    buffer_load_dwordx4 v59, s[20:23], s59 offen offset:3072 nt lds
    s_waitcnt vmcnt(32)
    s_barrier
L_lgo:
    s_mov_b32 s28, s18
    s_and_b32 s29, s19, 0xffff
    s_mov_b32 s30, 5023744
    s_mov_b32 s31, 0x20000
    s_mov_b64 s[96:97], s[16:17]
    v_and_b32 v17, 7, v0
    v_lshlrev_b32 v17, 5, v17
    v_mov_b32 v18, 0x7f000000
    v_mov_b32 v16, 0
    s_mov_b32 s94, -1
    s_mov_b32 s95, 0
    s_mov_b32 s61, 0
    s_sub_u32 s93, 256, s92
    s_bitcmp1_b32 s70, 0
    s_cselect_b32 s91, -3, 3
    s_mov_b32 s98, 0
    s_mov_b32 s99, 0
    s_add_u32 s100, s18, 4466688
    s_addc_u32 s101, s19, 0
    s_lshl_b32 s68, s70, 3
    s_cmp_eq_u32 s71, 30
    s_mov_b32 s3, -1
    s_cselect_b32 s59, 28, 0
    s_add_i32 s91, s91, s59
    s_mov_b64 s[72:73], 0
    s_mov_b64 s[74:75], 0
    s_mov_b64 s[76:77], 0
    s_branch L_lle
L_gx:
    s_mov_b32 s59, 0
    s_bcnt1_i32_b64 s60, s[72:73]
    s_add_i32 s59, s59, s60
    s_bitcmp1_b64 s[72:73], s68
    s_cselect_b32 s60, 8, 0
    s_sub_i32 s59, s59, s60
    s_bcnt1_i32_b64 s60, s[74:75]
    s_add_i32 s59, s59, s60
    s_bitcmp1_b64 s[74:75], s68
    s_cselect_b32 s60, 8, 0
    s_sub_i32 s59, s59, s60
    s_bcnt1_i32_b64 s60, s[76:77]
    s_add_i32 s59, s59, s60
    s_bitcmp1_b64 s[76:77], s68
    s_cselect_b32 s60, 8, 0
    s_sub_i32 s59, s59, s60
    s_add_u32 s60, s53, s93
    s_sub_u32 s60, s60, 130
    s_mul_i32 s60, s60, 4352
    s_load_dwordx2 s[72:73], s[100:101], s60 glc
    s_add_u32 s60, s53, s93
    s_sub_u32 s60, s60, 131
    s_mul_i32 s60, s60, 4352
    s_load_dwordx2 s[74:75], s[100:101], s60 glc
    s_add_u32 s60, s53, s93
    s_sub_u32 s60, s60, 132
    s_mul_i32 s60, s60, 4352
    s_load_dwordx2 s[76:77], s[100:101], s60 glc
    s_mul_i32 s59, s59, 8
    s_ashr_i32 s60, s99, 1
    s_sub_i32 s99, s99, s60
    s_add_i32 s99, s99, s59
    s_ashr_i32 s98, s99, 3
    s_min_i32 s98, s98, 24
    s_max_i32 s98, s98, -24
    s_add_u32 s59, s53, 8
    s_add_u32 s3, s53, 2
    s_cmp_lt_u32 s59, s92
    s_cselect_b32 s3, s3, -1
    s_branch L_gxd
L_ltop:
    s_cmp_eq_u32 s53, s3
    s_cbranch_scc1 L_gx
L_gxd:
    v_add_u32_dpp v3, v16, v16 row_ror:1 row_mask:0xf bank_mask:0xf
    v_cmp_gt_u32 vcc, 2, v16
    s_add_u32 s52, s53, s93
    v_add_u32_dpp v3, v3, v3 row_ror:2 row_mask:0xf bank_mask:0xf
    s_add_i32 s60, s52, s98
    v_mov_b32 v19, s60
    s_add_u32 s60, s61, 16
    v_add_u32_dpp v3, v3, v3 row_ror:4 row_mask:0xf bank_mask:0xf
    s_mov_b64 exec, 1
    buffer_store_dword v19, v18, s[28:31], 0 offen
    s_mov_b64 exec, s[94:95]
    global_load_dword v16, v17, s[96:97] sc1
    s_mov_b64 exec, -1
    v_add_u32_dpp v3, v3, v3 row_ror:8 row_mask:0xf bank_mask:0xf
    s_lshl_b32 s52, s52, 5
    v_readlane_b32 s59, v3, s61
    v_readlane_b32 s60, v3, s60
    s_xor_b32 s61, s61, 32
    s_add_u32 s59, s59, s60
    s_sub_i32 s52, s59, s52
    s_add_i32 s52, s52, s91
    s_and_b64 vcc, vcc, s[94:95]
    s_cselect_b32 s52, -80, s52
    s_not_b64 s[94:95], s[94:95]
    s_cmp_lg_u32 s59, 32
    s_cbranch_scc1 L_lsel
    s_mov_b64 s[96:97], s[18:19]
    s_lshl_b32 s59, s70, 8
    s_add_u32 s59, s59, 4464640
    v_and_b32 v17, 31, v0
    v_lshl_add_u32 v17, v17, 2, s59
    s_lshl2_add_u32 s59, s71, s59
    v_mov_b32 v18, s59
    v_mov_b32 v4, 159764
    s_add_u32 s59, s53, 7
    ds_write_b32 v4, v4
    s_cmp_eq_u32 s71, 30
    s_cselect_b32 s3, s59, -1
L_lsel:
    s_cmp_gt_i32 s52, -50
    s_cbranch_scc1 L_llf4
    s_cmp_gt_i32 s52, -70
    s_cbranch_scc1 L_llf3
    s_cmp_gt_i32 s52, -90
    s_cbranch_scc1 L_llf2
    s_cmp_gt_i32 s52, -110
    s_cbranch_scc1 L_llf1
L_llf0:
    s_add_u32 s57, s57, 1
    s_cmp_lg_u32 s57, s51
    s_cbranch_scc1 L_lsf0
    s_xor_b32 s62, s62, 1
    s_cselect_b32 s50, s50, s51
    s_cselect_b32 s20, s8, s6
    s_cselect_b32 s21, s9, s7
    s_mov_b32 s57, s50
    s_add_u32 s51, s50, 30
    s_min_u32 s51, s51, s56
L_lsf0:
    v_readlane_b32 s44, v36, s57
    v_readlane_b32 s45, v37, s57
    v_readlane_b32 s46, v38, s57
    v_readlane_b32 s47, v39, s57
    s_add_u32 m0, s58, 0
    s_bitcmp0_b32 s44, 0
    s_cselect_b32 s44, s44, 0
    s_cselect_b32 s22, 150994944, 0
    s_waitcnt vmcnt(21)
    buffer_load_dwordx4 v56, s[20:23], s44 offen offset:0 nt lds
    s_waitcnt vmcnt(19)
    buffer_load_dwordx4 v57, s[20:23], s44 offen offset:1024 nt lds
    s_waitcnt vmcnt(19)
    buffer_load_dwordx4 v58, s[20:23], s44 offen offset:2048 nt lds
    s_cmp_lt_u32 s53, 2
    s_waitcnt vmcnt(19)
    s_cbranch_scc1 L_lbf0
    s_barrier
L_lbf0:
    buffer_load_dwordx4 v59, s[20:23], s44 offen offset:3072 nt lds
    s_add_u32 m0, s58, 4096
    s_bitcmp0_b32 s45, 0
    s_cselect_b32 s45, s45, 0
    s_cselect_b32 s22, 150994944, 0
    s_waitcnt vmcnt(19)
    buffer_load_dwordx4 v56, s[20:23], s45 offen offset:0 nt lds
    s_waitcnt vmcnt(19)
    buffer_load_dwordx4 v57, s[20:23], s45 offen offset:1024 nt lds
    s_waitcnt vmcnt(19)
    buffer_load_dwordx4 v58, s[20:23], s45 offen offset:2048 nt lds
    s_waitcnt vmcnt(19)
    buffer_load_dwordx4 v59, s[20:23], s45 offen offset:3072 nt lds
    s_add_u32 m0, s58, 8192
    s_bitcmp0_b32 s46, 0
    s_cselect_b32 s46, s46, 0
    s_cselect_b32 s22, 150994944, 0
    s_waitcnt vmcnt(19)
    buffer_load_dwordx4 v56, s[20:23], s46 offen offset:0 nt lds
    s_waitcnt vmcnt(19)
    buffer_load_dwordx4 v57, s[20:23], s46 offen offset:1024 nt lds
    s_waitcnt vmcnt(19)
    buffer_load_dwordx4 v58, s[20:23], s46 offen offset:2048 nt lds
    s_waitcnt vmcnt(19)
    buffer_load_dwordx4 v59, s[20:23], s46 offen offset:3072 nt lds
    s_add_u32 m0, s58, 12288
    s_bitcmp0_b32 s47, 0
    s_cselect_b32 s47, s47, 0
    s_cselect_b32 s22, 150994944, 0
    s_waitcnt vmcnt(19)
    buffer_load_dwordx4 v56, s[20:23], s47 offen offset:0 nt lds
    s_waitcnt vmcnt(19)
    buffer_load_dwordx4 v57, s[20:23], s47 offen offset:1024 nt lds
    s_waitcnt vmcnt(19)
    buffer_load_dwordx4 v58, s[20:23], s47 offen offset:2048 nt lds
    s_waitcnt vmcnt(19)
    buffer_load_dwordx4 v59, s[20:23], s47 offen offset:3072 nt lds
    s_add_u32 s58, s58, 16384
    s_cmp_lg_u32 s58, 98304
    s_cselect_b32 s58, s58, 0
    s_add_u32 s53, s53, 1
    s_cmp_lt_u32 s53, s92
    s_cbranch_scc1 L_ltop
L_lfin:
    s_waitcnt vmcnt(16)
    s_barrier
    global_load_dword v3, v28, s[18:19] sc1
    global_load_dword v4, v29, s[18:19] sc1
    global_load_dword v5, v30, s[18:19] sc1
    s_waitcnt vmcnt(3)
    s_barrier
L_lend:
    s_waitcnt vmcnt(0) lgkmcnt(0)
    s_endpgm
L_llf1:
    s_add_u32 s57, s57, 1
    s_cmp_lg_u32 s57, s51
    s_cbranch_scc1 L_lsf1
    s_xor_b32 s62, s62, 1
    s_cselect_b32 s50, s50, s51
    s_cselect_b32 s20, s8, s6
    s_cselect_b32 s21, s9, s7
    s_mov_b32 s57, s50
    s_add_u32 s51, s50, 30
    s_min_u32 s51, s51, s56
L_lsf1:
    v_readlane_b32 s44, v36, s57
    v_readlane_b32 s45, v37, s57
    v_readlane_b32 s46, v38, s57
    v_readlane_b32 s47, v39, s57
    s_add_u32 m0, s58, 0
    s_bitcmp0_b32 s44, 0
    s_cselect_b32 s44, s44, 0
    s_cselect_b32 s22, 150994944, 0
    s_waitcnt vmcnt(23)
    buffer_load_dwordx4 v56, s[20:23], s44 offen offset:0 nt lds
    s_waitcnt vmcnt(23)
    buffer_load_dwordx4 v57, s[20:23], s44 offen offset:1024 nt lds
    s_waitcnt vmcnt(23)
    buffer_load_dwordx4 v58, s[20:23], s44 offen offset:2048 nt lds
    s_waitcnt vmcnt(21)
    buffer_load_dwordx4 v59, s[20:23], s44 offen offset:3072 nt lds
    s_add_u32 m0, s58, 4096
    s_bitcmp0_b32 s45, 0
    s_cselect_b32 s45, s45, 0
    s_cselect_b32 s22, 150994944, 0
    s_waitcnt vmcnt(21)
    buffer_load_dwordx4 v56, s[20:23], s45 offen offset:0 nt lds
    s_cmp_lt_u32 s53, 2
    s_waitcnt vmcnt(21)
    s_cbranch_scc1 L_lbf1
    s_barrier
L_lbf1:
    buffer_load_dwordx4 v57, s[20:23], s45 offen offset:1024 nt lds
    s_waitcnt vmcnt(21)
    buffer_load_dwordx4 v58, s[20:23], s45 offen offset:2048 nt lds
    s_waitcnt vmcnt(21)
    buffer_load_dwordx4 v59, s[20:23], s45 offen offset:3072 nt lds
    s_add_u32 m0, s58, 8192
    s_bitcmp0_b32 s46, 0
    s_cselect_b32 s46, s46, 0
    s_cselect_b32 s22, 150994944, 0
    s_waitcnt vmcnt(21)
    buffer_load_dwordx4 v56, s[20:23], s46 offen offset:0 nt lds
    s_waitcnt vmcnt(21)
    buffer_load_dwordx4 v57, s[20:23], s46 offen offset:1024 nt lds
    s_waitcnt vmcnt(21)
    buffer_load_dwordx4 v58, s[20:23], s46 offen offset:2048 nt lds
    s_waitcnt vmcnt(21)
    buffer_load_dwordx4 v59, s[20:23], s46 offen offset:3072 nt lds
    s_add_u32 m0, s58, 12288
    s_bitcmp0_b32 s47, 0
    s_cselect_b32 s47, s47, 0
    s_cselect_b32 s22, 150994944, 0
    s_waitcnt vmcnt(21)
    buffer_load_dwordx4 v56, s[20:23], s47 offen offset:0 nt lds
    s_waitcnt vmcnt(21)
    buffer_load_dwordx4 v57, s[20:23], s47 offen offset:1024 nt lds
    s_waitcnt vmcnt(21)
    buffer_load_dwordx4 v58, s[20:23], s47 offen offset:2048 nt lds
    s_waitcnt vmcnt(21)
    buffer_load_dwordx4 v59, s[20:23], s47 offen offset:3072 nt lds
    s_add_u32 s58, s58, 16384
    s_cmp_lg_u32 s58, 98304
    s_cselect_b32 s58, s58, 0
    s_add_u32 s53, s53, 1
    s_cmp_lt_u32 s53, s92
    s_cbranch_scc1 L_ltop
    s_branch L_lfin
L_llf2:
    s_add_u32 s57, s57, 1
    s_cmp_lg_u32 s57, s51
    s_cbranch_scc1 L_lsf2
    s_xor_b32 s62, s62, 1
    s_cselect_b32 s50, s50, s51
    s_cselect_b32 s20, s8, s6
    s_cselect_b32 s21, s9, s7
    s_mov_b32 s57, s50
    s_add_u32 s51, s50, 30
    s_min_u32 s51, s51, s56
L_lsf2:
    v_readlane_b32 s44, v36, s57
    v_readlane_b32 s45, v37, s57
    v_readlane_b32 s46, v38, s57
    v_readlane_b32 s47, v39, s57
    s_add_u32 m0, s58, 0
    s_bitcmp0_b32 s44, 0
    s_cselect_b32 s44, s44, 0
    s_cselect_b32 s22, 150994944, 0
    s_waitcnt vmcnt(24)
    buffer_load_dwordx4 v56, s[20:23], s44 offen offset:0 nt lds
    s_waitcnt vmcnt(24)
    buffer_load_dwordx4 v57, s[20:23], s44 offen offset:1024 nt lds
    s_waitcnt vmcnt(24)
    buffer_load_dwordx4 v58, s[20:23], s44 offen offset:2048 nt lds
    s_waitcnt vmcnt(24)
    buffer_load_dwordx4 v59, s[20:23], s44 offen offset:3072 nt lds
    s_add_u32 m0, s58, 4096
    s_bitcmp0_b32 s45, 0
    s_cselect_b32 s45, s45, 0
    s_cselect_b32 s22, 150994944, 0
    s_waitcnt vmcnt(22)
    buffer_load_dwordx4 v56, s[20:23], s45 offen offset:0 nt lds
    s_waitcnt vmcnt(22)
    buffer_load_dwordx4 v57, s[20:23], s45 offen offset:1024 nt lds
    s_cmp_lt_u32 s53, 2
    s_waitcnt vmcnt(22)
    s_cbranch_scc1 L_lbf2
    s_barrier
L_lbf2:
    buffer_load_dwordx4 v58, s[20:23], s45 offen offset:2048 nt lds
    s_waitcnt vmcnt(22)
    buffer_load_dwordx4 v59, s[20:23], s45 offen offset:3072 nt lds
    s_add_u32 m0, s58, 8192
    s_bitcmp0_b32 s46, 0
    s_cselect_b32 s46, s46, 0
    s_cselect_b32 s22, 150994944, 0
    s_waitcnt vmcnt(22)
    buffer_load_dwordx4 v56, s[20:23], s46 offen offset:0 nt lds
    s_waitcnt vmcnt(22)
    buffer_load_dwordx4 v57, s[20:23], s46 offen offset:1024 nt lds
    s_waitcnt vmcnt(22)
    buffer_load_dwordx4 v58, s[20:23], s46 offen offset:2048 nt lds
    s_waitcnt vmcnt(22)
    buffer_load_dwordx4 v59, s[20:23], s46 offen offset:3072 nt lds
    s_add_u32 m0, s58, 12288
    s_bitcmp0_b32 s47, 0
    s_cselect_b32 s47, s47, 0
    s_cselect_b32 s22, 150994944, 0
    s_waitcnt vmcnt(22)
    buffer_load_dwordx4 v56, s[20:23], s47 offen offset:0 nt lds
    s_waitcnt vmcnt(22)
    buffer_load_dwordx4 v57, s[20:23], s47 offen offset:1024 nt lds
    s_waitcnt vmcnt(22)
    buffer_load_dwordx4 v58, s[20:23], s47 offen offset:2048 nt lds
    s_waitcnt vmcnt(22)
    buffer_load_dwordx4 v59, s[20:23], s47 offen offset:3072 nt lds
    s_add_u32 s58, s58, 16384
    s_cmp_lg_u32 s58, 98304
    s_cselect_b32 s58, s58, 0
    s_add_u32 s53, s53, 1
    s_cmp_lt_u32 s53, s92
    s_cbranch_scc1 L_ltop
    s_branch L_lfin
L_llf3:
    s_add_u32 s57, s57, 1
    s_cmp_lg_u32 s57, s51
    s_cbranch_scc1 L_lsf3
    s_xor_b32 s62, s62, 1
    s_cselect_b32 s50, s50, s51
    s_cselect_b32 s20, s8, s6
    s_cselect_b32 s21, s9, s7
    s_mov_b32 s57, s50
    s_add_u32 s51, s50, 30
    s_min_u32 s51, s51, s56
L_lsf3:
    v_readlane_b32 s44, v36, s57
    v_readlane_b32 s45, v37, s57
    v_readlane_b32 s46, v38, s57
    v_readlane_b32 s47, v39, s57
    s_add_u32 m0, s58, 0
    s_bitcmp0_b32 s44, 0
    s_cselect_b32 s44, s44, 0
    s_cselect_b32 s22, 150994944, 0
    s_waitcnt vmcnt(26)
    buffer_load_dwordx4 v56, s[20:23], s44 offen offset:0 nt lds
    s_waitcnt vmcnt(26)
    buffer_load_dwordx4 v57, s[20:23], s44 offen offset:1024 nt lds
    s_waitcnt vmcnt(26)
    buffer_load_dwordx4 v58, s[20:23], s44 offen offset:2048 nt lds
    s_waitcnt vmcnt(26)
    buffer_load_dwordx4 v59, s[20:23], s44 offen offset:3072 nt lds
    s_add_u32 m0, s58, 4096
    s_bitcmp0_b32 s45, 0
    s_cselect_b32 s45, s45, 0
    s_cselect_b32 s22, 150994944, 0
    s_waitcnt vmcnt(26)
    buffer_load_dwordx4 v56, s[20:23], s45 offen offset:0 nt lds
    s_waitcnt vmcnt(26)
    buffer_load_dwordx4 v57, s[20:23], s45 offen offset:1024 nt lds
    s_waitcnt vmcnt(24)
    buffer_load_dwordx4 v58, s[20:23], s45 offen offset:2048 nt lds
    s_waitcnt vmcnt(24)
    buffer_load_dwordx4 v59, s[20:23], s45 offen offset:3072 nt lds
    s_add_u32 m0, s58, 8192
    s_bitcmp0_b32 s46, 0
    s_cselect_b32 s46, s46, 0
    s_cselect_b32 s22, 150994944, 0
    s_cmp_lt_u32 s53, 2
    s_waitcnt vmcnt(24)
    s_cbranch_scc1 L_lbf3
    s_barrier
L_lbf3:
    buffer_load_dwordx4 v56, s[20:23], s46 offen offset:0 nt lds
    s_waitcnt vmcnt(24)
    buffer_load_dwordx4 v57, s[20:23], s46 offen offset:1024 nt lds
    s_waitcnt vmcnt(24)
    buffer_load_dwordx4 v58, s[20:23], s46 offen offset:2048 nt lds
    s_waitcnt vmcnt(24)
    buffer_load_dwordx4 v59, s[20:23], s46 offen offset:3072 nt lds
    s_add_u32 m0, s58, 12288
    s_bitcmp0_b32 s47, 0
    s_cselect_b32 s47, s47, 0
    s_cselect_b32 s22, 150994944, 0
    s_waitcnt vmcnt(24)
    buffer_load_dwordx4 v56, s[20:23], s47 offen offset:0 nt lds
    s_waitcnt vmcnt(24)
    buffer_load_dwordx4 v57, s[20:23], s47 offen offset:1024 nt lds
    s_waitcnt vmcnt(24)
    buffer_load_dwordx4 v58, s[20:23], s47 offen offset:2048 nt lds
    s_waitcnt vmcnt(24)
    buffer_load_dwordx4 v59, s[20:23], s47 offen offset:3072 nt lds
    s_add_u32 s58, s58, 16384
    s_cmp_lg_u32 s58, 98304
    s_cselect_b32 s58, s58, 0
    s_add_u32 s53, s53, 1
    s_cmp_lt_u32 s53, s92
    s_cbranch_scc1 L_ltop
    s_branch L_lfin
L_llf4:
    s_add_u32 s57, s57, 1
    s_cmp_lg_u32 s57, s51
    s_cbranch_scc1 L_lsf4
    s_xor_b32 s62, s62, 1
    s_cselect_b32 s50, s50, s51
    s_cselect_b32 s20, s8, s6
    s_cselect_b32 s21, s9, s7
    s_mov_b32 s57, s50
    s_add_u32 s51, s50, 30
    s_min_u32 s51, s51, s56
L_lsf4:
    v_readlane_b32 s44, v36, s57
    v_readlane_b32 s45, v37, s57
    v_readlane_b32 s46, v38, s57
    v_readlane_b32 s47, v39, s57
    s_add_u32 m0, s58, 0
    s_bitcmp0_b32 s44, 0
    s_cselect_b32 s44, s44, 0
    s_cselect_b32 s22, 150994944, 0
    s_waitcnt vmcnt(30)
    buffer_load_dwordx4 v56, s[20:23], s44 offen offset:0 nt lds
    s_waitcnt vmcnt(30)
    buffer_load_dwordx4 v57, s[20:23], s44 offen offset:1024 nt lds
    s_waitcnt vmcnt(30)
    buffer_load_dwordx4 v58, s[20:23], s44 offen offset:2048 nt lds
    s_waitcnt vmcnt(30)
    buffer_load_dwordx4 v59, s[20:23], s44 offen offset:3072 nt lds
    s_add_u32 m0, s58, 4096
    s_bitcmp0_b32 s45, 0
    s_cselect_b32 s45, s45, 0
    s_cselect_b32 s22, 150994944, 0
    s_waitcnt vmcnt(30)
    buffer_load_dwordx4 v56, s[20:23], s45 offen offset:0 nt lds
    s_waitcnt vmcnt(30)
    buffer_load_dwordx4 v57, s[20:23], s45 offen offset:1024 nt lds
    s_waitcnt vmcnt(30)
    buffer_load_dwordx4 v58, s[20:23], s45 offen offset:2048 nt lds
    s_waitcnt vmcnt(30)
    buffer_load_dwordx4 v59, s[20:23], s45 offen offset:3072 nt lds
    s_add_u32 m0, s58, 8192
    s_bitcmp0_b32 s46, 0
    s_cselect_b32 s46, s46, 0
    s_cselect_b32 s22, 150994944, 0
    s_waitcnt vmcnt(30)
    buffer_load_dwordx4 v56, s[20:23], s46 offen offset:0 nt lds
    s_waitcnt vmcnt(30)
    buffer_load_dwordx4 v57, s[20:23], s46 offen offset:1024 nt lds
    s_waitcnt vmcnt(28)
    buffer_load_dwordx4 v58, s[20:23], s46 offen offset:2048 nt lds
    s_waitcnt vmcnt(28)
    buffer_load_dwordx4 v59, s[20:23], s46 offen offset:3072 nt lds
    s_add_u32 m0, s58, 12288
    s_bitcmp0_b32 s47, 0
    s_cselect_b32 s47, s47, 0
    s_cselect_b32 s22, 150994944, 0
    s_cmp_lt_u32 s53, 2
    s_waitcnt vmcnt(28)
    s_cbranch_scc1 L_lbf4
    s_barrier
L_lbf4:
    buffer_load_dwordx4 v56, s[20:23], s47 offen offset:0 nt lds
    s_waitcnt vmcnt(28)
    buffer_load_dwordx4 v57, s[20:23], s47 offen offset:1024 nt lds
    s_waitcnt vmcnt(28)
    buffer_load_dwordx4 v58, s[20:23], s47 offen offset:2048 nt lds
    s_waitcnt vmcnt(28)
    buffer_load_dwordx4 v59, s[20:23], s47 offen offset:3072 nt lds
    s_add_u32 s58, s58, 16384
    s_cmp_lg_u32 s58, 98304
    s_cselect_b32 s58, s58, 0
    s_add_u32 s53, s53, 1
    s_cmp_lt_u32 s53, s92
    s_cbranch_scc1 L_ltop
    s_branch L_lfin
L_lle:
    s_add_u32 s57, s57, 1
    s_cmp_lg_u32 s57, s51
    s_cbranch_scc1 L_lse
    s_xor_b32 s62, s62, 1
    s_cselect_b32 s50, s50, s51
    s_cselect_b32 s20, s8, s6
    s_cselect_b32 s21, s9, s7
    s_mov_b32 s57, s50
    s_add_u32 s51, s50, 30
    s_min_u32 s51, s51, s56
L_lse:
    v_readlane_b32 s44, v36, s57
    v_readlane_b32 s45, v37, s57
    v_readlane_b32 s46, v38, s57
    v_readlane_b32 s47, v39, s57
    s_add_u32 m0, s58, 0
    s_bitcmp0_b32 s44, 0
    s_cselect_b32 s44, s44, 0
    s_cselect_b32 s22, 150994944, 0
    s_waitcnt vmcnt(20)
    buffer_load_dwordx4 v56, s[20:23], s44 offen offset:0 nt lds
    s_waitcnt vmcnt(20)
    buffer_load_dwordx4 v57, s[20:23], s44 offen offset:1024 nt lds
    s_waitcnt vmcnt(20)
    buffer_load_dwordx4 v58, s[20:23], s44 offen offset:2048 nt lds
    s_waitcnt vmcnt(20)
    buffer_load_dwordx4 v59, s[20:23], s44 offen offset:3072 nt lds
    s_add_u32 m0, s58, 4096
    s_bitcmp0_b32 s45, 0
    s_cselect_b32 s45, s45, 0
    s_cselect_b32 s22, 150994944, 0
    s_cmp_lt_u32 s53, 2
    s_waitcnt vmcnt(20)
    s_cbranch_scc1 L_lbe
    s_barrier
L_lbe:
    buffer_load_dwordx4 v56, s[20:23], s45 offen offset:0 nt lds
    s_waitcnt vmcnt(20)
    buffer_load_dwordx4 v57, s[20:23], s45 offen offset:1024 nt lds
    s_waitcnt vmcnt(20)
    buffer_load_dwordx4 v58, s[20:23], s45 offen offset:2048 nt lds
    s_waitcnt vmcnt(20)
    buffer_load_dwordx4 v59, s[20:23], s45 offen offset:3072 nt lds
    s_add_u32 m0, s58, 8192
    s_bitcmp0_b32 s46, 0
    s_cselect_b32 s46, s46, 0
    s_cselect_b32 s22, 150994944, 0
    s_waitcnt vmcnt(20)
    buffer_load_dwordx4 v56, s[20:23], s46 offen offset:0 nt lds
    s_waitcnt vmcnt(20)
    buffer_load_dwordx4 v57, s[20:23], s46 offen offset:1024 nt lds
    s_waitcnt vmcnt(20)
    buffer_load_dwordx4 v58, s[20:23], s46 offen offset:2048 nt lds
    s_waitcnt vmcnt(20)
    buffer_load_dwordx4 v59, s[20:23], s46 offen offset:3072 nt lds
    s_add_u32 m0, s58, 12288
    s_bitcmp0_b32 s47, 0
    s_cselect_b32 s47, s47, 0
    s_cselect_b32 s22, 150994944, 0
    s_waitcnt vmcnt(20)
    buffer_load_dwordx4 v56, s[20:23], s47 offen offset:0 nt lds
    s_waitcnt vmcnt(20)
    buffer_load_dwordx4 v57, s[20:23], s47 offen offset:1024 nt lds
    s_waitcnt vmcnt(20)
    buffer_load_dwordx4 v58, s[20:23], s47 offen offset:2048 nt lds
    s_waitcnt vmcnt(20)
    buffer_load_dwordx4 v59, s[20:23], s47 offen offset:3072 nt lds
    s_add_u32 s58, s58, 16384
    s_cmp_lg_u32 s58, 98304
    s_cselect_b32 s58, s58, 0
    s_add_u32 s53, s53, 1
    s_cmp_lt_u32 s53, s92
    s_cbranch_scc0 L_lfin
    s_cmp_lt_u32 s53, 9
    s_cbranch_scc1 L_lle
    s_branch L_ltop
L_misspec:
    s_waitcnt vmcnt(0)
    s_cmp_eq_u32 s56, 0
    s_cbranch_scc1 L_lend
    s_mov_b32 s57, -1
    s_mov_b32 s53, 0
    s_branch L_lgo
L_cons:
    v_lshl_add_u32 v20, v3, 11, v4
    v_xor_b32 v4, v4, v5
    s_mov_b32 s38, 16384
    s_mov_b32 s39, 0x20000
    s_sub_u32 s91, s90, 64
    s_lshl_b32 s58, s91, 6
    s_lshl_b32 s72, s91, 3
    s_add_u32 s73, s72, 3072
    s_add_u32 s74, s72, 6144
    s_add_u32 s75, s72, 9216
    s_add_u32 m0, s58, 98304
    v_and_b32 v5, 14, v0
    v_lshlrev_b32 v5, 1, v5
    s_waitcnt lgkmcnt(0)
    s_mov_b32 s36, s10
    s_and_b32 s37, s11, 0xffff
    buffer_load_dwordx4 v20, s[36:39], s72 offen offset:0 lds
    buffer_load_dwordx4 v20, s[36:39], s73 offen offset:1024 lds
    buffer_load_dwordx4 v20, s[36:39], s74 offen offset:2048 lds
    buffer_load_dwordx4 v20, s[36:39], s75 offen offset:3072 lds
    global_load_dword v7, v5, s[12:13]
    s_lshr_b32 s90, s91, 6
    s_mov_b32 s34, 65536
    s_mov_b32 s35, 0x20000
    s_and_b32 s59, s90, 1
    s_lshl_b32 s59, s59, 7
    v_xor_b32 v4, s59, v4
    v_lshl_add_u32 v50, v3, 9, v4
    v_xor_b32 v51, 64, v50
    s_lshl4_add_u32 s61, s90, s70
    s_lshl_b32 s61, s61, 10
    s_add_u32 s60, s61, 7168
    s_lshr_b32 s59, s58, 1
    s_add_u32 m0, s59, 131072
    s_mov_b32 s32, s4
    s_and_b32 s33, s5, 0xffff
    buffer_load_dwordx4 v50, s[32:35], s61 offen lds
    buffer_load_dwordx4 v51, s[32:35], s60 offen offset:1024 lds
    v_and_b32 v0, 63, v0
    s_xor_b32 s59, s71, 31
    s_or_b32 s59, s59, s90
    s_cselect_b32 s41, 0, 1
    s_cbranch_scc0 L_clear
L_cleared:
    s_add_u32 s59, s58, 98304
    v_lshl_add_u32 v14, v0, 3, s59
    v_lshrrev_b32 v1, 4, v0
    v_and_b32 v2, 15, v0
    s_lshl2_add_u32 s59, s90, 159744
    v_mov_b32 v30, s59
    v_mov_b32 v31, 159744
    s_lshl2_add_u32 s59, s90, 147456
    v_lshl_add_u32 v32, v0, 4, s59
    s_lshl_b32 s93, s90, 6
    v_lshl_add_u32 v20, v0, 5, s71
    v_mov_b32 v48, 0x80000
    v_not_b32 v21, v20
    v_mov_b32 v49, 0x7fff0000
    v_lshrrev_b32 v28, 1, v2
    v_lshlrev_b32 v28, 16, v28
    v_and_b32 v3, 7, v2
    v_lshlrev_b32 v3, 1, v3
    v_xor_b32 v3, v3, v1
    v_lshlrev_b32 v3, 4, v3
    v_lshl_add_u32 v52, v2, 9, v3
    v_xor_b32 v53, 64, v52
    v_xor_b32 v54, 128, v52
    v_xor_b32 v55, 192, v52
    v_lshrrev_b32 v3, 2, v0
    v_lshlrev_b32 v4, 9, v3
    v_and_b32 v3, 7, v3
    v_lshlrev_b32 v3, 1, v3
    v_and_b32 v5, 3, v0
    s_lshl_b32 s59, s90, 3
    v_add_u32 v5, s59, v5
    v_xor_b32 v6, v5, v3
    v_lshl_add_u32 v60, v6, 4, v4
    v_xor_b32 v61, 64, v60
    v_add_u32 v160, 131072, v52
    v_add_u32 v161, 131072, v53
    v_add_u32 v162, 131072, v54
    v_add_u32 v163, 131072, v55
    s_and_b32 s59, s90, 1
    s_lshl_b32 s61, s59, 4
    s_lshl_b32 s68, s59, 6
    s_add_u32 s68, s68, s70
    s_lshl_b32 s68, s68, 9
    v_mov_b32 v5, 0x2000
    v_mov_b32 v6, 1035512379
    s_waitcnt vmcnt(2)
    ds_read_b64 v[96:97], v14 offset:0
    ds_read_b64 v[98:99], v14 offset:512
    ds_read_b64 v[100:101], v14 offset:1024
    ds_read_b64 v[102:103], v14 offset:1536
    ds_read_b64 v[104:105], v14 offset:2048
    ds_read_b64 v[106:107], v14 offset:2560
    ds_read_b64 v[108:109], v14 offset:3072
    ds_read_b64 v[110:111], v14 offset:3584
    v_cmp_lt_i32 vcc, 0, v7
    v_min_i32 v7, 0x2000, v7
    v_lshl_add_u32 v3, v1, 2, s61
    v_cndmask_b32 v7, v5, v7, vcc
    v_cndmask_b32 v8, 0, v6, vcc
    v_add_u32 v15, 31, v7
    v_lshrrev_b32 v15, 5, v15
    v_sub_u32 v44, v7, v3
    v_subrev_u32 v45, 1, v44
    v_max_u32_dpp v5, v15, v15 row_ror:2 row_mask:0xf bank_mask:0xf
    v_subrev_u32 v46, 2, v44
    v_subrev_u32 v47, 3, v44
    v_max_u32_dpp v5, v5, v5 row_ror:4 row_mask:0xf bank_mask:0xf
    s_waitcnt lgkmcnt(0)
    v_cmp_ne_u64 s[74:75], v[96:97], v[98:99]
    v_cmp_ne_u64 s[76:77], v[96:97], v[100:101]
    v_cmp_ne_u64 s[78:79], v[96:97], v[102:103]
    v_cmp_ne_u64 s[80:81], v[96:97], v[104:105]
    v_cmp_ne_u64 s[82:83], v[96:97], v[106:107]
    v_cmp_ne_u64 s[84:85], v[96:97], v[108:109]
    v_cmp_ne_u64 s[86:87], v[96:97], v[110:111]
    v_max_u32_dpp v5, v5, v5 row_ror:8 row_mask:0xf bank_mask:0xf
    s_or_b64 s[74:75], s[74:75], s[76:77]
    s_or_b64 s[74:75], s[74:75], s[78:79]
    s_or_b64 s[74:75], s[74:75], s[80:81]
    s_or_b64 s[74:75], s[74:75], s[82:83]
    s_or_b64 s[74:75], s[74:75], s[84:85]
    s_or_b64 s[74:75], s[74:75], s[86:87]
    s_ff1_i32_b64 s59, s[74:75]
    s_min_u32 s59, s59, 256
    s_add_u32 s59, s59, s93
    v_min_u32 v5, s59, v5
    ds_write_b32 v30, v5
    s_waitcnt lgkmcnt(0)
    s_barrier
    ds_read_b128 v[36:39], v31
    s_waitcnt lgkmcnt(0)
    v_min3_u32 v3, v36, v37, v38
    v_min_u32 v3, v3, v39
    v_max_u32 v15, v15, v3
    v_sub_u32 v15, v15, v3
    v_mov_b32 v176, 0
    v_mov_b32 v177, 0
    v_add_u32_dpp v4, v15, v15 row_shr:2 row_mask:0xf bank_mask:0xf bound_ctrl:0
    v_mov_b32 v178, 0
    v_mov_b32 v179, 0
    v_add_u32_dpp v4, v4, v4 row_shr:4 row_mask:0xf bank_mask:0xf bound_ctrl:0
    v_mov_b32 v9, 4278190080
    v_mov_b32 v10, 0
    v_add_u32_dpp v4, v4, v4 row_shr:8 row_mask:0xf bank_mask:0xf bound_ctrl:0
    v_add_u32 v5, v4, v3
    v_sub_u32 v4, v4, v15
    v_readlane_b32 s92, v5, 15
    v_sub_u32 v5, v5, v15
    v_sub_u32 v4, v28, v4
    s_mov_b32 s57, 0
    v_add_co_u32_dpp v6, vcc, v5, v21 row_newbcast:0 row_mask:0xf bank_mask:0xf
    v_mov_b32 v180, 0
    v_mov_b32 v181, 0
    v_cndmask_b32_dpp v48, v4, v48, vcc row_newbcast:0 row_mask:0xf bank_mask:0xf
    v_add_co_u32_dpp v6, vcc, v5, v21 row_newbcast:2 row_mask:0xf bank_mask:0xf
    v_mov_b32 v182, 0
    v_mov_b32 v183, 0
    v_cndmask_b32_dpp v48, v4, v48, vcc row_newbcast:2 row_mask:0xf bank_mask:0xf
    v_add_co_u32_dpp v6, vcc, v5, v21 row_newbcast:4 row_mask:0xf bank_mask:0xf
    v_mov_b32 v184, 0
    v_mov_b32 v185, 0
    v_cndmask_b32_dpp v48, v4, v48, vcc row_newbcast:4 row_mask:0xf bank_mask:0xf
    v_add_co_u32_dpp v6, vcc, v5, v21 row_newbcast:6 row_mask:0xf bank_mask:0xf
    v_mov_b32 v186, 0
    v_mov_b32 v187, 0
    v_cndmask_b32_dpp v48, v4, v48, vcc row_newbcast:6 row_mask:0xf bank_mask:0xf
    v_add_co_u32_dpp v6, vcc, v5, v21 row_newbcast:8 row_mask:0xf bank_mask:0xf
    v_mov_b32 v188, 0
    v_mov_b32 v189, 0
    v_cndmask_b32_dpp v48, v4, v48, vcc row_newbcast:8 row_mask:0xf bank_mask:0xf
    v_add_co_u32_dpp v6, vcc, v5, v21 row_newbcast:10 row_mask:0xf bank_mask:0xf
    v_mov_b32 v190, 0
    v_mov_b32 v191, 0
    v_cndmask_b32_dpp v48, v4, v48, vcc row_newbcast:10 row_mask:0xf bank_mask:0xf
    v_add_co_u32_dpp v6, vcc, v5, v21 row_newbcast:12 row_mask:0xf bank_mask:0xf
    v_mov_b32 v50, 0xff800000
    s_mov_b32 s54, 0x00030003
    v_cndmask_b32_dpp v48, v4, v48, vcc row_newbcast:12 row_mask:0xf bank_mask:0xf
    v_add_co_u32_dpp v6, vcc, v5, v21 row_newbcast:14 row_mask:0xf bank_mask:0xf
    s_mov_b32 s55, 0x00030003
    s_mov_b32 s40, 0
    v_cndmask_b32_dpp v48, v4, v48, vcc row_newbcast:14 row_mask:0xf bank_mask:0xf
    v_cmp_gt_u32 s[74:75], s92, v20
    v_add_u32 v48, v48, v20
    v_bfe_u32 v4, v48, 16, 3
    v_bfe_u32 v5, v48, 6, 2
    v_and_b32 v3, 0x3f, v48
    v_lshl_add_u32 v5, v5, 3, v4
    v_lshl_add_u32 v3, v5, 6, v3
    s_and_b32 s59, s90, 2
    s_lshl1_add_u32 s59, s59, 98304
    v_lshl_add_u32 v3, v3, 3, s59
    v_lshlrev_b32 v4, 3, v4
    ds_read_b32 v14, v3
    ds_bpermute_b32 v4, v4, v7
    s_bcnt1_i32_b64 s56, s[74:75]
    v_and_b32 v3, 0xff, v48
    s_lshl_b32 s60, s90, 3
    v_lshl_add_u32 v3, v3, 5, s60
    v_cmp_le_u32 vcc, 0x80000, v48
    v_mov_b32 v5, s56
    ds_write_b32 v31, v5 offset:16
    ds_write_b32 v31, v176 offset:20
    s_waitcnt lgkmcnt(2)
    v_cmp_lt_u32 s[72:73], v3, v4
    v_lshl_add_u32 v14, v14, 16, s68
    s_or_b64 vcc, vcc, s[72:73]
    s_and_b64 vcc, vcc, s[74:75]
    v_cndmask_b32 v14, 1, v14, vcc
    ds_write_b32 v32, v14
    s_cmp_eq_u32 s41, 1
    s_waitcnt vmcnt(0) lgkmcnt(0)
    s_barrier
    s_cbranch_scc1 L_ready
L_readied:
    s_mov_b32 s52, 0
    s_cmp_eq_u32 s56, 0
    s_cbranch_scc1 L_done
    ds_read_b128 v[64:67], v160 offset:0
    ds_read_b128 v[68:71], v161 offset:0
    ds_read_b128 v[72:75], v162 offset:0
    ds_read_b128 v[76:79], v163 offset:0
    ds_read_b128 v[80:83], v160 offset:256
    ds_read_b128 v[84:87], v161 offset:256
    ds_read_b128 v[88:91], v162 offset:256
    ds_read_b128 v[92:95], v163 offset:256
    s_lshl_b32 s59, s61, 9
    v_add_u32 v52, s59, v52
    v_lshlrev_b32 v57, 4, v0
    v_add_u32 v57, 98304, v57
    s_lshl_b32 s59, s61, 6
    v_add_u32 v56, s59, v57
    v_lshlrev_b32 v59, 4, v2
    v_add_u32 v59, 159808, v59
    s_lshl_b32 s59, s90, 2
    v_add_u32 v58, s59, v59
    s_mov_b32 s69, 0
    s_mov_b32 s50, 0
    s_min_u32 s51, s56, 30
    s_lshr_b32 s62, s90, 1
    s_add_u32 s101, s70, 4462336
    v_mov_b32 v204, 0
    v_mov_b32 v205, 1
    s_lshl_b32 s59, s56, 1
    s_sub_u32 s3, 128, s59
    s_cmp_eq_u32 s90, 3
    s_cselect_b32 s100, s71, 99
    s_branch L_pass
L_clear:
    s_lshl_b32 s59, s70, 10
    s_add_u32 s59, s59, 4456448
    v_lshl_add_u32 v201, v0, 3, s59
    v_mov_b32 v202, 0
    v_mov_b32 v203, 0
    global_store_dwordx2 v201, v[202:203], s[18:19] sc1
    global_store_dwordx2 v201, v[202:203], s[18:19] offset:512 sc1
    s_lshl_b32 s59, s70, 8
    s_add_u32 s59, s59, 4464640
    v_lshl_add_u32 v201, v0, 2, s59
    global_store_dword v201, v202, s[18:19] sc1
    s_mul_i32 s59, s70, 69632
    s_add_u32 s59, s59, 4466688
    v_mul_u32_u24 v201, 4352, v0
    v_add_u32 v201, s59, v201
    s_mov_b64 exec, 0xffff
    global_store_dwordx2 v201, v[202:203], s[18:19] sc1
    s_mov_b64 exec, -1
    s_branch L_cleared
L_ready:
    s_lshl_b32 s59, s70, 5
    v_mov_b32 v201, s59
    v_mov_b32 v202, 1
    s_mov_b64 exec, 1
    global_store_dword v201, v202, s[16:17] sc1
    s_mov_b64 exec, -1
    s_branch L_readied
L_late:
    s_mov_b32 s28, s18
    s_and_b32 s29, s19, 0xffff
    s_mov_b32 s30, 5023744
    s_mov_b32 s31, 0x20000
    s_lshl2_add_u32 s60, s70, s90
    s_lshl_b32 s59, s60, 9
    s_add_u32 s59, s59, s71
    s_lshl_b32 s59, s59, 3
    s_add_u32 s59, s59, 2097152
    v_lshl_add_u32 v63, v2, 8, s59
    s_lshl_b32 s60, s60, 8
    s_lshl2_add_u32 s60, s71, s60
    s_add_u32 s60, s60, 4456448
    v_mov_b32 v197, s60
    s_lshl_b32 s59, s70, 5
    v_mov_b32 v198, s59
    s_add_u32 s59, s59, s71
    s_lshl2_add_u32 s59, s59, s90
    s_lshl_b32 s59, s59, 11
    v_lshl_add_u32 v62, v2, 6, s59
    v_lshl_add_u32 v62, v1, 4, v62
    v_lshrrev_b32 v202, 2, v0
    v_and_b32 v203, 3, v0
    s_lshr_b32 s91, s71, 2
    s_and_b32 s59, s90, 1
    s_lshl1_add_u32 s61, s91, s59
    s_lshl1_add_u32 s93, s70, s59
    s_and_b32 s92, s71, 3
    s_lshr_b32 s60, s90, 1
    s_lshl1_add_u32 s68, s92, s60
    s_lshl2_add_u32 s92, s70, s92
    s_lshl_b32 s59, s92, 12
    s_lshl_b32 s60, s61, 8
    s_add_u32 s59, s59, s60
    s_add_u32 s59, s59, 2097152
    v_lshl_add_u32 v194, v202, 3, s59
    s_lshl_b32 s59, s92, 8
    s_add_u32 s59, s59, 4456448
    v_lshl_add_u32 v195, v0, 2, s59
    s_lshl_b32 s59, s70, 18
    s_lshl4_add_u32 s60, s68, s61
    s_lshl_b32 s60, s60, 6
    s_add_u32 s59, s59, s60
    v_lshl_add_u32 v192, v203, 4, s59
    v_lshl_add_u32 v192, v202, 13, v192
    v_add_u32 v193, 131072, v192
    s_lshl4_add_u32 s59, s91, s93
    s_lshl3_add_u32 s59, s59, s68
    s_lshl_b32 s59, s59, 6
    v_lshl_add_u32 v196, v203, 4, s59
    v_lshl_add_u32 v196, v1, 2, v196
    s_getreg_b32 s43, hwreg(HW_REG_XCC_ID, 0, 4)
L_late_end:
    s_cmp_eq_u32 s40, 2
    s_cbranch_scc1 L_done2
    s_mov_b32 s40, 1
    s_branch L_back
L_late2:
    s_mov_b32 s40, 2
    s_branch L_late
.p2align 6
L_pass:
    v_mov_b32 v15, v9
L_p1:
    s_xor_b32 s59, s57, s62
    s_bitcmp0_b32 s59, 0
    s_cbranch_scc1 L_mine
    s_barrier
    s_and_b32 s59, s3, 31
    s_add_u32 s3, s3, 1
    s_cmp_lg_u32 s59, s100
    s_cbranch_scc1 L_hk1
    s_cmp_gt_u32 s3, 120
    s_cbranch_scc1 L_hk1
    v_mov_b32 v204, 159764
    ds_read_b32 v204, v204
    s_mul_i32 s59, s3, 4352
    s_add_u32 s59, s59, s101
    s_waitcnt lgkmcnt(0)
    v_cmp_ne_u32 vcc, 0, v204
    s_cbranch_vccz L_hk1
    s_mov_b64 exec, 1
    v_mov_b32 v204, s59
    global_store_byte v204, v205, s[18:19] sc1
    s_mov_b64 exec, -1
L_hk1:
    s_lshr_b32 s59, s57, 1
    s_cmp_eq_u32 s59, 2
    s_cbranch_scc1 L_late
    s_branch L_back
L_mine:
    v_readlane_b32 s52, v48, s57
    v_add_u32 v32, s69, v52
    v_xor_b32 v33, 64, v32
    v_xor_b32 v34, 128, v32
    v_xor_b32 v35, 192, v32
    s_lshr_b32 s59, s52, 15
    s_lshl_b64 vcc, s[54:55], s59
    s_bitcmp1_b32 s52, 19
    s_cselect_b64 vcc, -1, vcc
    s_and_b32 s52, s52, 255
    s_lshl_b32 s52, s52, 5
    v_mov_b32 v4, s52
    v_cndmask_b32 v4, v49, v4, vcc
    s_sub_u32 s59, s57, s50
    s_lshl_b32 s59, s59, 11
    v_cmp_lt_i32 s[72:73], v4, v44
    v_cmp_lt_i32 s[74:75], v4, v45
    v_cmp_lt_i32 s[76:77], v4, v46
    v_cmp_lt_i32 s[78:79], v4, v47
    v_add_u32 v5, s59, v56
    s_barrier
    s_and_b32 s59, s3, 31
    s_add_u32 s3, s3, 1
    s_cmp_lg_u32 s59, s100
    s_cbranch_scc1 L_hk2
    s_cmp_gt_u32 s3, 120
    s_cbranch_scc1 L_hk2
    v_mov_b32 v204, 159764
    ds_read_b32 v204, v204
    s_mul_i32 s59, s3, 4352
    s_add_u32 s59, s59, s101
    s_waitcnt lgkmcnt(0)
    v_cmp_ne_u32 vcc, 0, v204
    s_cbranch_vccz L_hk2
    s_mov_b64 exec, 1
    v_mov_b32 v204, s59
    global_store_byte v204, v205, s[18:19] sc1
    s_mov_b64 exec, -1
L_hk2:
    ds_read_b128 v[96:99], v32 offset:0
    ds_read_b128 v[100:103], v33 offset:0
    ds_read_b128 v[104:107], v34 offset:0
    ds_read_b128 v[108:111], v35 offset:0
    ds_read_b128 v[112:115], v32 offset:256
    ds_read_b128 v[116:119], v33 offset:256
    ds_read_b128 v[120:123], v34 offset:256
    ds_read_b128 v[124:127], v35 offset:256
    s_waitcnt lgkmcnt(7)
    v_mfma_f32_16x16x32_bf16 v[20:23], v[96:99], v[64:67], 0
    s_waitcnt lgkmcnt(6)
    v_mfma_f32_16x16x32_bf16 v[20:23], v[100:103], v[68:71], v[20:23]
    s_waitcnt lgkmcnt(5)
    v_mfma_f32_16x16x32_bf16 v[20:23], v[104:107], v[72:75], v[20:23]
    s_waitcnt lgkmcnt(4)
    v_mfma_f32_16x16x32_bf16 v[20:23], v[108:111], v[76:79], v[20:23]
    s_waitcnt lgkmcnt(3)
    v_mfma_f32_16x16x32_bf16 v[20:23], v[112:115], v[80:83], v[20:23]
    s_waitcnt lgkmcnt(2)
    v_mfma_f32_16x16x32_bf16 v[20:23], v[116:119], v[84:87], v[20:23]
    s_waitcnt lgkmcnt(1)
    v_mfma_f32_16x16x32_bf16 v[20:23], v[120:123], v[88:91], v[20:23]
    s_waitcnt lgkmcnt(0)
    v_mfma_f32_16x16x32_bf16 v[20:23], v[124:127], v[92:95], v[20:23]
    s_nop 7
    v_mul_f32 v36, v20, v8
    v_mul_f32 v37, v21, v8
    v_mul_f32 v38, v22, v8
    v_mul_f32 v39, v23, v8
    v_cndmask_b32 v36, v50, v36, s[72:73]
    v_cndmask_b32 v37, v50, v37, s[74:75]
    v_cndmask_b32 v38, v50, v38, s[76:77]
    v_cndmask_b32 v39, v50, v39, s[78:79]
    ds_write_b128 v5, v[36:39]
    v_max3_f32 v15, v15, v36, v37
    v_max3_f32 v15, v15, v38, v39
L_back:
    s_add_u32 s69, s69, 16384
    s_cmp_lg_u32 s69, 98304
    s_cselect_b32 s69, s69, 0
    s_add_u32 s57, s57, 1
    s_cmp_lt_u32 s57, s51
    s_cbranch_scc1 L_p1
    v_mov_b32 v4, v15
    s_mov_b32 s57, s50
    s_nop 0
    v_permlane32_swap_b32 v15, v4
    v_max_f32 v15, v15, v4
    v_mov_b32 v4, v15
    s_nop 1
    v_permlane16_swap_b32 v15, v4
    v_max_f32 v15, v15, v4
    ds_write_b32 v58, v15
    v_mov_b32 v6, v57
    s_waitcnt lgkmcnt(0)
    s_barrier
    s_and_b32 s59, s3, 31
    s_add_u32 s3, s3, 1
    s_cmp_lg_u32 s59, s100
    s_cbranch_scc1 L_hk3
    s_cmp_gt_u32 s3, 120
    s_cbranch_scc1 L_hk3
    v_mov_b32 v204, 159764
    ds_read_b32 v204, v204
    s_mul_i32 s59, s3, 4352
    s_add_u32 s59, s59, s101
    s_waitcnt lgkmcnt(0)
    v_cmp_ne_u32 vcc, 0, v204
    s_cbranch_vccz L_hk3
    s_mov_b64 exec, 1
    v_mov_b32 v204, s59
    global_store_byte v204, v205, s[18:19] sc1
    s_mov_b64 exec, -1
L_hk3:
    ds_read_b128 v[20:23], v59
    s_mov_b32 s53, 0
    s_waitcnt lgkmcnt(0)
    v_max3_f32 v3, v20, v21, v22
    v_max_f32 v3, v3, v23
    v_sub_f32 v12, v9, v3
    v_exp_f32 v12, v12
    v_mov_b32 v9, v3
    v_mul_f32 v10, v10, v12
    v_pk_mul_f32 v[176:177], v[176:177], v[12:13] op_sel_hi:[1,0]
    v_pk_mul_f32 v[178:179], v[178:179], v[12:13] op_sel_hi:[1,0]
    v_pk_mul_f32 v[180:181], v[180:181], v[12:13] op_sel_hi:[1,0]
    v_pk_mul_f32 v[182:183], v[182:183], v[12:13] op_sel_hi:[1,0]
    v_pk_mul_f32 v[184:185], v[184:185], v[12:13] op_sel_hi:[1,0]
    v_pk_mul_f32 v[186:187], v[186:187], v[12:13] op_sel_hi:[1,0]
    v_pk_mul_f32 v[188:189], v[188:189], v[12:13] op_sel_hi:[1,0]
    v_pk_mul_f32 v[190:191], v[190:191], v[12:13] op_sel_hi:[1,0]
L_p2:
    ds_read_b128 v[36:39], v6
    ds_read_b128 v[40:43], v6 offset:1024
    v_add_u32 v32, s69, v60
    v_add_u32 v33, s69, v61
    v_add_u32 v6, 2048, v6
    s_add_u32 s69, s69, 16384
    s_cmp_lg_u32 s69, 98304
    s_cselect_b32 s69, s69, 0
    s_add_u32 s57, s57, 1
    s_cmp_eq_u32 s53, 0
    s_mov_b32 s53, 1
    s_waitcnt lgkmcnt(0)
    v_sub_f32 v36, v36, v9
    v_sub_f32 v37, v37, v9
    v_sub_f32 v38, v38, v9
    v_sub_f32 v39, v39, v9
    v_sub_f32 v40, v40, v9
    v_sub_f32 v41, v41, v9
    v_sub_f32 v42, v42, v9
    v_sub_f32 v43, v43, v9
    v_exp_f32 v36, v36
    v_exp_f32 v37, v37
    v_exp_f32 v38, v38
    v_exp_f32 v39, v39
    v_exp_f32 v40, v40
    v_exp_f32 v41, v41
    v_exp_f32 v42, v42
    v_exp_f32 v43, v43
    v_cvt_pk_bf16_f32 v16, v36, v37
    v_cvt_pk_bf16_f32 v17, v38, v39
    v_cvt_pk_bf16_f32 v18, v40, v41
    v_cvt_pk_bf16_f32 v19, v42, v43
    v_add_f32 v10, v10, v36
    v_add_f32 v3, v37, v38
    v_add_f32 v4, v39, v40
    v_add_f32 v5, v41, v42
    v_add_f32 v10, v10, v43
    v_add_f32 v3, v3, v4
    v_add_f32 v10, v10, v5
    v_add_f32 v10, v10, v3
    s_cselect_b32 s52, 1, 2
    s_cmp_eq_u32 s57, s56
    s_cbranch_scc1 L_done
    s_cmp_eq_u32 s52, 1
    s_cbranch_scc1 L_nb
    s_barrier
    s_and_b32 s59, s3, 31
    s_add_u32 s3, s3, 1
    s_cmp_lg_u32 s59, s100
    s_cbranch_scc1 L_hk4
    s_cmp_gt_u32 s3, 120
    s_cbranch_scc1 L_hk4
    v_mov_b32 v204, 159764
    ds_read_b32 v204, v204
    s_mul_i32 s59, s3, 4352
    s_add_u32 s59, s59, s101
    s_waitcnt lgkmcnt(0)
    v_cmp_ne_u32 vcc, 0, v204
    s_cbranch_vccz L_hk4
    s_mov_b64 exec, 1
    v_mov_b32 v204, s59
    global_store_byte v204, v205, s[18:19] sc1
    s_mov_b64 exec, -1
L_hk4:
L_nb:
    ds_read_b64_tr_b16 v[160:161], v32 offset:0
    ds_read_b64_tr_b16 v[162:163], v32 offset:8192
    ds_read_b64_tr_b16 v[164:165], v32 offset:8
    ds_read_b64_tr_b16 v[166:167], v32 offset:8200
    ds_read_b64_tr_b16 v[168:169], v33 offset:0
    ds_read_b64_tr_b16 v[170:171], v33 offset:8192
    ds_read_b64_tr_b16 v[172:173], v33 offset:8
    ds_read_b64_tr_b16 v[174:175], v33 offset:8200
    s_cmp_lt_u32 s57, s51
    s_waitcnt lgkmcnt(6)
    v_mfma_f32_16x16x32_bf16 v[176:179], v[160:163], v[16:19], v[176:179]
    s_waitcnt lgkmcnt(4)
    v_mfma_f32_16x16x32_bf16 v[180:183], v[164:167], v[16:19], v[180:183]
    s_waitcnt lgkmcnt(2)
    v_mfma_f32_16x16x32_bf16 v[184:187], v[168:171], v[16:19], v[184:187]
    s_waitcnt lgkmcnt(0)
    v_mfma_f32_16x16x32_bf16 v[188:191], v[172:175], v[16:19], v[188:191]
    s_cbranch_scc1 L_p2
    s_mov_b32 s50, s51
    s_add_u32 s51, s51, 30
    s_min_u32 s51, s51, s56
    s_branch L_pass
L_done:
    s_cmp_eq_u32 s40, 0
    s_cbranch_scc1 L_late2
L_done2:
    global_load_dword v3, v198, s[16:17] sc1
    v_mov_b32 v4, v10
    v_mov_b32 v12, v9
    s_mov_b32 s42, 0
    v_permlane32_swap_b32 v10, v4
    v_add_f32 v10, v10, v4
    v_mov_b32 v4, v10
    s_mov_b32 s41, 0
    v_mov_b32 v5, 1
    v_permlane16_swap_b32 v10, v4
    v_add_f32 v13, v10, v4
    s_cmp_lg_u32 s43, s70
    s_cbranch_scc1 L_noml
    s_mov_b64 exec, 0xffff
    buffer_store_dwordx2 v[12:13], v63, s[28:31], 0 offen
    s_mov_b64 exec, -1
L_noml:
    s_cmp_eq_u32 s52, 0
    s_cbranch_scc1 L_nopv
    s_cmp_eq_u32 s52, 1
    s_cbranch_scc1 L_nb2
    s_barrier
L_nb2:
    ds_read_b64_tr_b16 v[160:161], v32 offset:0
    ds_read_b64_tr_b16 v[162:163], v32 offset:8192
    ds_read_b64_tr_b16 v[164:165], v32 offset:8
    ds_read_b64_tr_b16 v[166:167], v32 offset:8200
    ds_read_b64_tr_b16 v[168:169], v33 offset:0
    ds_read_b64_tr_b16 v[170:171], v33 offset:8192
    ds_read_b64_tr_b16 v[172:173], v33 offset:8
    ds_read_b64_tr_b16 v[174:175], v33 offset:8200
    s_waitcnt lgkmcnt(6)
    v_mfma_f32_16x16x32_bf16 v[176:179], v[160:163], v[16:19], v[176:179]
    s_waitcnt lgkmcnt(4)
    v_mfma_f32_16x16x32_bf16 v[180:183], v[164:167], v[16:19], v[180:183]
    s_waitcnt lgkmcnt(2)
    v_mfma_f32_16x16x32_bf16 v[184:187], v[168:171], v[16:19], v[184:187]
    s_waitcnt lgkmcnt(0)
    v_mfma_f32_16x16x32_bf16 v[188:191], v[172:175], v[16:19], v[188:191]
L_nopv:
    s_cmp_eq_u32 s43, s70
    s_nop 2
    v_cvt_pk_bf16_f32 v36, v176, v177
    v_cvt_pk_bf16_f32 v37, v178, v179
    v_cvt_pk_bf16_f32 v38, v180, v181
    v_cvt_pk_bf16_f32 v39, v182, v183
    s_nop 0
    v_cvt_pk_bf16_f32 v40, v184, v185
    v_cvt_pk_bf16_f32 v41, v186, v187
    v_cvt_pk_bf16_f32 v42, v188, v189
    v_cvt_pk_bf16_f32 v43, v190, v191
    s_cbranch_scc0 L_slow
    buffer_store_dwordx4 v[36:39], v62, s[28:31], s41 offen offset:0
    buffer_store_dwordx4 v[40:43], v62, s[28:31], s41 offen offset:1024
    s_mov_b64 exec, 1
L_rdya:
    s_waitcnt vmcnt(0)
    v_cmp_eq_u32 vcc, 0, v3
    s_cbranch_vccz L_roka
    s_add_u32 s42, s42, 1
    s_cmp_ge_u32 s42, 0x40000
    s_cbranch_scc1 L_roka
    global_load_dword v3, v198, s[16:17] sc1
    s_branch L_rdya
L_roka:
    buffer_store_dword v5, v197, s[28:31], 0 offen offset:0
    s_mov_b64 exec, -1
L_poll:
    buffer_load_dword v6, v195, s[28:31], 0 offen sc1
    s_add_u32 s42, s42, 1
    s_waitcnt vmcnt(0)
    v_cmp_ne_u32 vcc, 0, v6
    s_cmp_eq_u32 vcc_lo, -1
    s_cbranch_scc1 L_got
    s_cmp_lg_u32 vcc_hi, 0
    s_cbranch_scc1 L_slow
    s_cmp_lt_u32 s42, 0x40000
    s_cbranch_scc1 L_poll
L_got:
    buffer_load_dwordx2 v[104:105], v194, s[28:31], s41 offen offset:0 sc1
    buffer_load_dwordx2 v[106:107], v194, s[28:31], s41 offen offset:128 sc1
    buffer_load_dwordx4 v[96:99], v192, s[28:31], s41 offen sc1
    buffer_load_dwordx4 v[100:103], v193, s[28:31], s41 offen sc1
    s_waitcnt vmcnt(2)
    v_max_f32 v3, v104, v106
    s_nop 1
    v_max_f32_dpp v3, v3, v3 row_ror:4 row_mask:0xf bank_mask:0xf
    s_nop 1
    v_max_f32_dpp v3, v3, v3 row_ror:8 row_mask:0xf bank_mask:0xf
    v_mov_b32 v4, v3
    s_nop 1
    v_permlane32_swap_b32 v3, v4
    v_max_f32 v3, v3, v4
    v_mov_b32 v4, v3
    s_nop 1
    v_permlane16_swap_b32 v3, v4
    v_max_f32 v3, v3, v4
    v_sub_f32 v104, v104, v3
    v_sub_f32 v106, v106, v3
    v_exp_f32 v104, v104
    v_exp_f32 v106, v106
    v_mul_f32 v120, v104, v105
    v_fmac_f32 v120, v106, v107
    s_waitcnt vmcnt(1)
    v_lshlrev_b32 v4, 16, v96
    v_and_b32 v5, 0xffff0000, v96
    v_mul_f32 v112, v104, v4
    v_mul_f32 v113, v104, v5
    v_lshlrev_b32 v4, 16, v97
    v_and_b32 v5, 0xffff0000, v97
    v_mul_f32 v114, v104, v4
    v_mul_f32 v115, v104, v5
    v_lshlrev_b32 v4, 16, v98
    v_and_b32 v5, 0xffff0000, v98
    v_mul_f32 v116, v104, v4
    v_mul_f32 v117, v104, v5
    v_lshlrev_b32 v4, 16, v99
    v_and_b32 v5, 0xffff0000, v99
    v_mul_f32 v118, v104, v4
    v_mul_f32 v119, v104, v5
    s_waitcnt vmcnt(0)
    v_lshlrev_b32 v4, 16, v100
    v_and_b32 v5, 0xffff0000, v100
    v_fmac_f32 v112, v106, v4
    v_fmac_f32 v113, v106, v5
    v_lshlrev_b32 v4, 16, v101
    v_and_b32 v5, 0xffff0000, v101
    v_fmac_f32 v114, v106, v4
    v_fmac_f32 v115, v106, v5
    v_lshlrev_b32 v4, 16, v102
    v_and_b32 v5, 0xffff0000, v102
    v_fmac_f32 v116, v106, v4
    v_fmac_f32 v117, v106, v5
    v_lshlrev_b32 v4, 16, v103
    v_and_b32 v5, 0xffff0000, v103
    v_fmac_f32 v118, v106, v4
    v_fmac_f32 v119, v106, v5
    v_mov_b32 v121, v120
    v_permlane32_swap_b32 v112, v116
    v_permlane32_swap_b32 v113, v117
    v_permlane32_swap_b32 v114, v118
    v_permlane32_swap_b32 v115, v119
    v_permlane32_swap_b32 v120, v121
    v_add_f32 v120, v120, v121
    v_add_f32 v112, v112, v116
    v_add_f32 v113, v113, v117
    v_add_f32 v114, v114, v118
    v_add_f32 v115, v115, v119
    v_mov_b32 v121, v120
    s_nop 0
    v_permlane16_swap_b32 v112, v114
    v_permlane16_swap_b32 v113, v115
    v_permlane16_swap_b32 v120, v121
    v_add_f32 v120, v120, v121
    v_add_f32 v112, v112, v114
    v_add_f32 v113, v113, v115
    v_add_f32_dpp v120, v120, v120 row_ror:4 row_mask:0xf bank_mask:0xf
    v_add_f32_dpp v112, v112, v112 row_ror:4 row_mask:0xf bank_mask:0xf
    v_add_f32_dpp v113, v113, v113 row_ror:4 row_mask:0xf bank_mask:0xf
    v_add_f32_dpp v120, v120, v120 row_ror:8 row_mask:0xf bank_mask:0xf
    v_add_f32_dpp v112, v112, v112 row_ror:8 row_mask:0xf bank_mask:0xf
    v_add_f32_dpp v113, v113, v113 row_ror:8 row_mask:0xf bank_mask:0xf
    v_rcp_f32 v120, v120
    s_mov_b32 exec_lo, 0x000f000f
    s_mov_b32 exec_hi, 0x000f000f
    v_mul_f32 v112, v112, v120
    v_mul_f32 v113, v113, v120
    v_cvt_pk_bf16_f32 v112, v112, v113
    global_store_dword v196, v112, s[14:15]
    s_endpgm
L_slow:
    s_mov_b32 s41, 2228224
    buffer_store_dwordx4 v[36:39], v62, s[28:31], s41 offen offset:0 sc1
    buffer_store_dwordx4 v[40:43], v62, s[28:31], s41 offen offset:1024 sc1
    s_mov_b64 exec, 0xffff
    buffer_store_dwordx2 v[12:13], v63, s[28:31], s41 offen sc1
    s_mov_b64 exec, 1
L_rdyb:
    s_waitcnt vmcnt(0)
    v_cmp_eq_u32 vcc, 0, v3
    s_cbranch_vccz L_rokb
    s_add_u32 s42, s42, 1
    s_cmp_ge_u32 s42, 0x40000
    s_cbranch_scc1 L_rokb
    global_load_dword v3, v198, s[16:17] sc1
    s_branch L_rdyb
L_rokb:
    buffer_store_dword v5, v197, s[28:31], 0 offen offset:128 sc1
    s_mov_b64 exec, -1
L_poll2:
    buffer_load_dword v6, v195, s[28:31], 0 offen sc1
    s_add_u32 s42, s42, 1
    s_waitcnt vmcnt(0)
    v_cmp_ne_u32 vcc, 0, v6
    s_cmp_eq_u32 vcc_hi, -1
    s_cbranch_scc1 L_got
    s_sleep 2
    s_cmp_lt_u32 s42, 0x40000
    s_cbranch_scc1 L_poll2
    s_branch L_got
L_end:
    s_endpgm
.section .rodata,"a"
.p2align 6
.amdhsa_kernel standalone__paged_block_table_kv_radixattention__sampling_kernel
.amdhsa_next_free_vgpr 208
.amdhsa_next_free_sgpr 102
.amdhsa_accum_offset 208
.amdhsa_group_segment_fixed_size 0
.amdhsa_kernarg_size 64
.amdhsa_user_sgpr_count 2
.amdhsa_user_sgpr_kernarg_segment_ptr 1
.amdhsa_system_sgpr_workgroup_id_x 1
.end_amdhsa_kernel
```
